```python
import torch

def _softmax(x, axis=-1):
    return torch.softmax(x, dim=axis)
def _gelu(x):
    return torch.nn.functional.gelu(x, approximate="tanh")
def _silu(x):
    return torch.nn.functional.silu(x)
def _sigmoid(x):
    return torch.sigmoid(x)
def _layernorm(x, axis=-1, eps=1e-5):
    m = x.mean(dim=axis, keepdim=True)
    v = x.var(dim=axis, keepdim=True, unbiased=False)
    return (x - m) / torch.sqrt(v + eps)
def _scatter_add(tgt, idx, src, axis=0):
    return tgt.clone().index_add_(axis, idx, src)
def _segment_sum(src, seg, n):
    out = torch.zeros((n,) + src.shape[1:], dtype=src.dtype)
    return out.index_add_(0, seg, src)
def _pad(x, pw):
    flat = tuple(v for pair in reversed(pw) for v in pair)
    return torch.nn.functional.pad(x, flat)

kernel_name = 'parallel_sum__sliding_block_cached__dense_activation_silu__decode'

def setup_inputs():

    _w = (lambda a: (lambda t: t.to(torch.bfloat16) if t.is_floating_point() else t)(torch.as_tensor(a)))
    def _A_setup():
        B, Sq, D = 1, 1, 640
        Hq, Hkv, Sk, Dh = 32, 32, 4096, 128
        assert Hq % Hkv == 0, (Hq, Hkv)
        return {
            "x": _w((lambda *s: torch.randn(*s, dtype=torch.bfloat16) * 0.05)(B, Sq, D)),
            "k_cache": _w((lambda *s: torch.randn(*s, dtype=torch.bfloat16) * 3.2)(B, Hkv, Sk, Dh)),
            "v_cache": _w((lambda *s: torch.randn(*s, dtype=torch.bfloat16) * 0.8)(B, Hkv, Sk, Dh)),
            "wq": _w((lambda *s: torch.randn(*s, dtype=torch.bfloat16) * 3.2)(D, Hq * Dh) * (D ** -0.5)),
            "wo": _w((lambda *s: torch.randn(*s, dtype=torch.bfloat16) * 0.8)(Hq * Dh, D) * ((Hq * Dh) ** -0.5)),
        }
    _A_in = _A_setup()

    def _B_setup():
        B, S, D, F = 1, 1, 640, 1728
        return {
            "x": _w((lambda *s: torch.randn(*s, dtype=torch.bfloat16) * 0.05)(B, S, D)),
            "w1": _w((lambda *s: torch.randn(*s, dtype=torch.bfloat16) * 3.2)(D, F) * (D ** -0.5)),
            "w2": _w((lambda *s: torch.randn(*s, dtype=torch.bfloat16) * 0.4)(F, D) * (F ** -0.5)),
        }
    _B_in = _B_setup()

    return {
        "A_x": _A_in["x"],
        "A_k_cache": _A_in["k_cache"],
        "A_v_cache": _A_in["v_cache"],
        "A_wq": _A_in["wq"],
        "A_wo": _A_in["wo"],
        "B_x": _B_in["x"],
        "B_w1": _B_in["w1"],
        "B_w2": _B_in["w2"],
    }

def reference(A_x, A_k_cache, A_v_cache, A_wq, A_wo, B_x, B_w1, B_w2):
    def _A_ref(x, k_cache, v_cache, wq, wo):
        B, Sq, D = x.shape
        Hq, Dh = 32, 128
        Hkv, Sk = k_cache.shape[1], k_cache.shape[2]
        W = min(4096, max(256, Sk // 4))
        rep = Hq // Hkv
        q = (lambda x, *d: x.permute(*d))((x @ wq).reshape(B, Sq, Hq, Dh), 0, 2, 1, 3)
        k = (lambda x, n, axis: torch.repeat_interleave(x, n, dim=axis))(k_cache[:, :, Sk - W:, :], rep, axis=1)
        v = (lambda x, n, axis: torch.repeat_interleave(x, n, dim=axis))(v_cache[:, :, Sk - W:, :], rep, axis=1)
        scores = torch.einsum("bhqd,bhkd->bhqk", q, k) * (Dh ** -0.5)
        p = _softmax(scores, axis=-1)
        o = torch.einsum("bhqk,bhkd->bhqd", p, v)
        return (lambda x, *d: x.permute(*d))(o, 0, 2, 1, 3).reshape(B, Sq, Hq * Dh) @ wo

    def _B_ref(x, w1, w2):
        h = torch.einsum("bsd,df->bsf", x, w1)
        h = _silu(h)
        out = torch.einsum("bsf,fd->bsd", h, w2)
        return out

    x = A_x
    xn = _layernorm(x, axis=-1)
    return x + _A_ref(xn, A_k_cache, A_v_cache, A_wq, A_wo) + _B_ref(xn, B_w1, B_w2)
```

```asm
; @launch grid=(256,1,1) block=(256,1,1) lds=83968
.amdgcn_target "amdgcn-amd-amdhsa--gfx950"
.text
.globl parallel_sum__sliding_block_cached__dense_activation_silu__decode_kernel
.p2align 8
.type parallel_sum__sliding_block_cached__dense_activation_silu__decode_kernel,@function
parallel_sum__sliding_block_cached__dense_activation_silu__decode_kernel:
  s_load_dwordx16 s[4:19], s[0:1], 0
  s_load_dwordx2 s[20:21], s[0:1], 64
  s_load_dwordx2 s[52:53], s[0:1], 80
  s_getpc_b64 s[28:29]
L_pc:
  s_cmpk_ge_u32 s2, 256
  s_cbranch_scc1 L_end
  v_lshlrev_b32 v48, 7, v0
  v_min_u32 v48, L_end - L_pc, v48
  v_lshrrev_b32 v40, 6, v0
  v_and_b32 v3, 63, v0
  v_readfirstlane_b32 s26, v40
  global_load_dword v90, v48, s[28:29]
  v_and_b32 v1, 15, v0
  v_bfe_u32 v2, v0, 4, 2
  s_and_b32 s24, s2, 31
  s_lshr_b32 s25, s2, 5
  v_lshlrev_b32 v8, 4, v3
  v_lshlrev_b32 v9, 2, v3
  v_lshlrev_b32 v42, 4, v1
  v_mad_u32_u24 v41, v40, 20, v2
  v_lshl_add_u32 v4, v41, 13, v42
  s_movk_i32 s30, 1280
  s_mov_b32 s31, 0x20000
  s_mov_b32 s42, 5242880
  s_mov_b32 s43, 0x20000
  s_mul_i32 s64, s25, 655360
  s_lshl_b32 s68, s24, 8
  s_add_u32 s64, s64, s68
  s_waitcnt lgkmcnt(0)
  s_mov_b64 s[28:29], s[4:5]
  buffer_load_dwordx4 v[64:67], v8, s[28:31], 0 offen
  buffer_load_dword v68, v9, s[28:31], 0 offen offset:1024
  s_mov_b64 s[40:41], s[10:11]
  buffer_load_dwordx4 v[96:99], v4, s[40:43], s64 offen nt
  s_add_u32 s64, s64, 0x8000
  buffer_load_dwordx4 v[100:103], v4, s[40:43], s64 offen nt
  s_add_u32 s64, s64, 0x8000
  buffer_load_dwordx4 v[104:107], v4, s[40:43], s64 offen nt
  s_add_u32 s64, s64, 0x8000
  buffer_load_dwordx4 v[108:111], v4, s[40:43], s64 offen nt
  s_add_u32 s64, s64, 0x8000
  buffer_load_dwordx4 v[112:115], v4, s[40:43], s64 offen nt
  v_lshl_add_u32 v5, v40, 13, v8
  s_mov_b64 s[32:33], s[6:7]
  s_mov_b32 s34, 0x2000000
  s_mov_b32 s35, 0x20000
  s_mov_b32 s54, 0x10000000
  s_mov_b32 s55, 0x20000
  s_lshl_b32 s65, s24, 20
  s_add_u32 s65, s65, 786432
  s_lshl_b32 s68, s25, 10
  s_add_u32 s65, s65, s68
  s_lshl_b32 s72, s24, 3
  s_add_u32 s72, s72, s25
  s_lshl_b32 s100, s72, 9
  s_add_u32 s100, s100, 4096
  s_lshl_b32 s101, s72, 10
  s_add_u32 s101, s101, 135168
  s_lshl_b32 s69, s26, 7
  s_add_u32 s69, s69, s100
  v_mov_b32 v51, 0
  s_barrier
  buffer_load_dword v15, v51, s[52:55], 0 offen
  buffer_load_dword v88, v51, s[52:55], s69 offen sc1
  buffer_load_dwordx4 v[128:131], v5, s[32:35], s65 offen offset:0 nt
  s_add_u32 s70, s65, 32768
  buffer_load_dwordx4 v[132:135], v5, s[32:35], s70 offen offset:0 nt
  s_mov_b64 s[36:37], s[8:9]
  s_mov_b64 s[44:45], s[16:17]
  s_mov_b64 s[60:61], s[16:17]
  s_mov_b32 s38, 0x2000000
  s_mov_b32 s39, 0x20000
  s_mov_b32 s47, 0x20000
  s_mov_b32 s63, 0x20000
  s_mov_b32 s51, 0x20000
  s_mov_b32 s6, 0x07060500
  s_mov_b32 s7, 0x07060501
  s_mov_b32 s8, 0x07060502
  s_mov_b32 s9, 0x07060503
  s_mov_b32 s10, 0x0c0c0400
  s_mov_b32 s11, 0x05040100
  v_lshrrev_b32 v43, 3, v1
  v_lshl_add_u32 v44, v43, 2, v2
  v_lshl_add_u32 v44, v40, 3, v44
  v_and_b32 v45, 7, v1
  v_mul_u32_u24 v7, 3456, v44
  v_lshl_add_u32 v7, v45, 4, v7
  s_mov_b32 s97, s24
  s_cmp_lt_u32 s25, 5
  s_cselect_b32 s96, s24, s97
  s_lshl_b32 s69, s97, 7
  s_mul_i32 s67, s25, 276480
  s_add_u32 s67, s67, s69
  s_cmp_lt_u32 s97, 27
  s_cselect_b32 s46, 2211840, 0
  s_cselect_b32 s98, 8, 5
  s_cmp_lt_u32 s26, 2
  s_cselect_b32 s62, s46, 0
  s_mul_i32 s68, s25, 160
  v_lshl_add_u32 v10, v41, 1, s68
  s_mul_i32 s68, s25, 160
  v_lshl_add_u32 v11, v44, 1, s68
  s_cmp_lt_u32 s25, 5
  s_cselect_b64 s[48:49], s[12:13], s[18:19]
  s_cselect_b32 s68, 3, 1
  s_and_b32 s68, s68, s26
  s_lshl_b32 s68, s68, 2
  v_add_u32 v46, s68, v2
  v_mul_u32_u24 v6, 10240, v46
  v_add_u32 v6, v6, v42
  s_lshr_b32 s68, s26, 1
  s_lshl_b32 s69, s25, 1
  s_add_u32 s68, s68, s69
  s_sub_u32 s68, s68, 10
  s_cmp_lt_u32 s25, 5
  s_cselect_b32 s68, s25, s68
  s_mov_b32 s69, 81920
  s_cselect_b32 s69, 163840, s69
  s_mul_i32 s66, s96, s69
  s_lshl_b32 s69, s68, 8
  s_add_u32 s66, s66, s69
  s_add_u32 s71, s66, 5120
  s_cmp_lt_u32 s68, 5
  s_cselect_b32 s50, s46, 0
  s_cmp_lt_u32 s25, 5
  s_cselect_b32 s50, 5242880, s50
  s_cselect_b32 s69, 0, 512
  s_lshl_b32 s68, s24, 13
  s_add_u32 s68, s68, 135168
  v_lshl_add_u32 v81, v45, 10, s68
  v_lshl_add_u32 v14, v46, 5, v81
  v_lshl_add_u32 v14, v43, 4, v14
  v_add_u32 v14, s69, v14
  s_lshl_b32 s68, s24, 2
  s_add_u32 s68, s68, s26
  s_lshl_b32 s68, s68, 10
  s_add_u32 s68, s68, 4096
  v_add_u32 v80, s68, v8
  v_and_b32 v47, 1, v2
  v_lshrrev_b32 v48, 1, v2
  v_lshl_add_u32 v48, v40, 1, v48
  v_lshlrev_b32 v12, 9, v48
  v_lshl_add_u32 v12, v1, 5, v12
  v_lshl_add_u32 v12, v47, 4, v12
  v_lshlrev_b32 v13, 8, v48
  v_lshl_add_u32 v13, v45, 5, v13
  v_lshl_add_u32 v13, v47, 4, v13
  v_and_b32 v82, 7, v3
  v_lshrrev_b32 v49, 3, v3
  v_lshl_add_u32 v50, v40, 3, v49
  v_lshlrev_b32 v83, 4, v50
  v_lshl_add_u32 v84, v82, 9, v83
  v_lshl_add_u32 v87, v40, 2, v49
  v_lshlrev_b32 v87, 4, v87
  v_lshlrev_b32 v49, 4, v49
  v_add_u32 v49, 768, v49
  v_cmp_eq_u32 vcc, 0, v82
  v_lshrrev_b32 v47, 2, v82
  v_lshrrev_b32 v48, 2, v50
  v_cndmask_b32 v86, v49, v83, vcc
  v_lshl_add_u32 v47, v47, 3, v48
  v_and_b32 v48, 48, v83
  v_lshl_add_u32 v85, v47, 13, v48
  s_lshl_b32 s72, s25, 17
  s_sub_u32 s72, s72, 651264
  s_lshl_b32 s73, s25, 16
  s_cmp_lt_u32 s25, 5
  s_cselect_b32 s72, s73, s72
  s_lshl_b32 s73, s96, 7
  s_add_u32 s72, s72, s73
  s_add_u32 s72, s72, 397312
  s_lshl_b32 s68, s26, 14
  s_add_u32 s68, s68, s72
  v_and_b32 v47, 1, v3
  v_bfe_u32 v48, v3, 2, 1
  v_lshlrev_b32 v89, 13, v47
  v_lshl_add_u32 v89, v48, 16, v89
  v_add_u32 v89, s68, v89
  s_lshl_b32 s68, s26, 7
  s_add_u32 s68, s68, s101
  v_writelane_b32 v89, s68, 0
  s_add_u32 s68, s68, 512
  v_writelane_b32 v89, s68, 1
  s_getreg_b32 s99, hwreg(HW_REG_XCC_ID)
  s_lshl_b32 s99, s99, 8
  s_mov_b64 exec, 3
  buffer_load_dword v88, v89, s[52:55], 0 offen sc1
  s_mov_b64 exec, -1
  v_and_b32 v47, 1, v1
  v_cmp_eq_u32 vcc, 1, v47
  v_mov_b32 v48, 0x0c0c0100
  v_mov_b32 v49, 0x01000c0c
  v_cndmask_b32 v48, v48, v49, vcc
  v_mov_b32 v49, 0x0c0c0302
  v_mov_b32 v50, 0x03020c0c
  v_cndmask_b32 v49, v49, v50, vcc
  v_lshrrev_b32 v47, 1, v45
  v_mov_b32 v50, 0x0c0c0c0c
  v_cmp_eq_u32 vcc, 0, v47
  s_nop 1
  v_cndmask_b32 v16, v50, v48, vcc
  v_cndmask_b32 v20, v50, v49, vcc
  v_cmp_eq_u32 vcc, 1, v47
  s_nop 1
  v_cndmask_b32 v17, v50, v48, vcc
  v_cndmask_b32 v21, v50, v49, vcc
  v_cmp_eq_u32 vcc, 2, v47
  s_nop 1
  v_cndmask_b32 v18, v50, v48, vcc
  v_cndmask_b32 v22, v50, v49, vcc
  v_cmp_eq_u32 vcc, 3, v47
  s_nop 1
  v_cndmask_b32 v19, v50, v48, vcc
  v_cndmask_b32 v23, v50, v49, vcc
  s_mov_b32 s27, 0x3fb8aa3b
  s_waitcnt vmcnt(10)
  s_add_u32 s70, s65, 65536
  buffer_load_dwordx4 v[136:139], v5, s[32:35], s70 offen offset:0 nt
  s_add_u32 s70, s65, 98304
  buffer_load_dwordx4 v[140:143], v5, s[32:35], s70 offen offset:0 nt
  v_lshlrev_b32 v40, 16, v64
  v_and_b32 v41, 0xffff0000, v64
  v_lshlrev_b32 v42, 16, v65
  v_and_b32 v43, 0xffff0000, v65
  v_lshlrev_b32 v44, 16, v66
  v_and_b32 v45, 0xffff0000, v66
  v_lshlrev_b32 v46, 16, v67
  v_and_b32 v47, 0xffff0000, v67
  v_lshlrev_b32 v48, 16, v68
  v_and_b32 v49, 0xffff0000, v68
  v_add_f32 v50, v40, v41
  v_add_f32 v50, v50, v42
  v_add_f32 v50, v50, v43
  v_add_f32 v50, v50, v44
  v_add_f32 v50, v50, v45
  v_add_f32 v50, v50, v46
  v_add_f32 v50, v50, v47
  v_add_f32 v50, v50, v48
  v_add_f32 v50, v50, v49
  s_nop 1
  v_add_f32_dpp v50, v50, v50 row_ror:8 row_mask:0xf bank_mask:0xf
  s_nop 1
  v_add_f32_dpp v50, v50, v50 row_ror:4 row_mask:0xf bank_mask:0xf
  s_nop 1
  v_add_f32_dpp v50, v50, v50 row_ror:2 row_mask:0xf bank_mask:0xf
  s_nop 1
  v_add_f32_dpp v50, v50, v50 row_ror:1 row_mask:0xf bank_mask:0xf
  s_nop 1
  v_add_f32_dpp v50, v50, v50 row_bcast:15 row_mask:0xa bank_mask:0xf
  s_nop 1
  v_add_f32_dpp v50, v50, v50 row_bcast:31 row_mask:0xc bank_mask:0xf
  s_nop 0
  v_readlane_b32 s68, v50, 63
  s_nop 1
  v_mov_b32 v61, 0x3acccccd
  v_mul_f32 v50, s68, v61
  v_sub_f32 v51, v40, v50
  v_sub_f32 v52, v41, v50
  v_sub_f32 v53, v42, v50
  v_sub_f32 v54, v43, v50
  v_sub_f32 v55, v44, v50
  v_sub_f32 v56, v45, v50
  v_sub_f32 v57, v46, v50
  v_sub_f32 v58, v47, v50
  v_sub_f32 v59, v48, v50
  v_sub_f32 v60, v49, v50
  v_mul_f32 v62, v51, v51
  v_fmac_f32 v62, v52, v52
  v_fmac_f32 v62, v53, v53
  v_fmac_f32 v62, v54, v54
  v_fmac_f32 v62, v55, v55
  v_fmac_f32 v62, v56, v56
  v_fmac_f32 v62, v57, v57
  v_fmac_f32 v62, v58, v58
  v_fmac_f32 v62, v59, v59
  v_fmac_f32 v62, v60, v60
  v_cvt_pk_bf16_f32 v50, v50, v50
  v_and_b32 v50, 0xffff0000, v50
  s_add_u32 s70, s65, 131072
  buffer_load_dwordx4 v[144:147], v5, s[32:35], s70 offen offset:0 nt
  s_add_u32 s70, s65, 163840
  buffer_load_dwordx4 v[148:151], v5, s[32:35], s70 offen offset:0 nt
  s_nop 1
  v_add_f32_dpp v62, v62, v62 row_ror:8 row_mask:0xf bank_mask:0xf
  s_nop 1
  v_add_f32_dpp v62, v62, v62 row_ror:4 row_mask:0xf bank_mask:0xf
  s_nop 1
  v_add_f32_dpp v62, v62, v62 row_ror:2 row_mask:0xf bank_mask:0xf
  s_nop 1
  v_add_f32_dpp v62, v62, v62 row_ror:1 row_mask:0xf bank_mask:0xf
  s_nop 1
  v_add_f32_dpp v62, v62, v62 row_bcast:15 row_mask:0xa bank_mask:0xf
  s_nop 1
  v_add_f32_dpp v62, v62, v62 row_bcast:31 row_mask:0xc bank_mask:0xf
  s_nop 0
  v_readlane_b32 s68, v62, 63
  s_nop 1
  v_mul_f32 v62, s68, v61
  v_cvt_pk_bf16_f32 v62, v62, v62
  v_and_b32 v62, 0xffff0000, v62
  v_add_f32 v62, 0x3727c5ac, v62
  v_cvt_pk_bf16_f32 v62, v62, v62
  v_and_b32 v62, 0xffff0000, v62
  v_sqrt_f32 v62, v62
  v_sub_f32 v51, v40, v50
  v_sub_f32 v52, v41, v50
  v_sub_f32 v53, v42, v50
  v_sub_f32 v54, v43, v50
  v_sub_f32 v55, v44, v50
  v_sub_f32 v56, v45, v50
  v_sub_f32 v57, v46, v50
  v_sub_f32 v58, v47, v50
  v_sub_f32 v59, v48, v50
  v_sub_f32 v60, v49, v50
  v_cvt_pk_bf16_f32 v62, v62, v62
  v_and_b32 v62, 0xffff0000, v62
  v_rcp_f32 v62, v62
  v_cvt_pk_bf16_f32 v40, v51, v52
  v_cvt_pk_bf16_f32 v41, v53, v54
  v_cvt_pk_bf16_f32 v42, v55, v56
  v_cvt_pk_bf16_f32 v43, v57, v58
  v_cvt_pk_bf16_f32 v44, v59, v60
  v_lshlrev_b32 v51, 16, v40
  v_and_b32 v52, 0xffff0000, v40
  v_lshlrev_b32 v53, 16, v41
  v_and_b32 v54, 0xffff0000, v41
  v_lshlrev_b32 v55, 16, v42
  v_and_b32 v56, 0xffff0000, v42
  v_lshlrev_b32 v57, 16, v43
  v_and_b32 v58, 0xffff0000, v43
  v_lshlrev_b32 v59, 16, v44
  v_and_b32 v60, 0xffff0000, v44
  v_mul_f32 v51, v51, v62
  v_mul_f32 v52, v52, v62
  v_mul_f32 v53, v53, v62
  v_mul_f32 v54, v54, v62
  v_mul_f32 v55, v55, v62
  v_mul_f32 v56, v56, v62
  v_mul_f32 v57, v57, v62
  v_mul_f32 v58, v58, v62
  v_mul_f32 v59, v59, v62
  v_mul_f32 v60, v60, v62
  v_cvt_pk_bf16_f32 v40, v51, v52
  v_cvt_pk_bf16_f32 v41, v53, v54
  v_cvt_pk_bf16_f32 v42, v55, v56
  v_cvt_pk_bf16_f32 v43, v57, v58
  v_cvt_pk_bf16_f32 v44, v59, v60
  ds_write_b128 v8, v[40:43] offset:0
  ds_write_b32 v9, v44 offset:1024
  s_cmp_lt_u32 s26, 2
  s_cselect_b32 s68, 128, 0
  v_add_u32 v45, s68, v11
  s_waitcnt lgkmcnt(0)
  ds_read_u16 v72, v10 offset:0
  ds_read_u16 v73, v10 offset:8
  ds_read_u16 v74, v10 offset:16
  ds_read_u16 v75, v10 offset:24
  ds_read_u16 v76, v10 offset:32
  ds_read_u16 v77, v11 offset:0
  ds_read_u16 v78, v11 offset:64
  ds_read_u16 v79, v45 offset:0
  v_lshlrev_b32 v60, 5, v1
  v_lshl_add_u32 v60, v2, 4, v60
  s_lshl_b32 s68, s26, 9
  v_add_u32 v60, s68, v60
  v_and_b32 v61, 3, v3
  v_lshrrev_b32 v62, 2, v3
  v_lshlrev_b32 v62, 4, v62
  s_lshl_b32 s68, s26, 7
  v_add_u32 v62, s68, v62
  v_lshl_add_u32 v61, v61, 9, v62
  s_waitcnt lgkmcnt(3)
  v_perm_b32 v32, v72, v72, v16
  v_perm_b32 v33, v72, v72, v17
  v_perm_b32 v34, v72, v72, v18
  v_perm_b32 v35, v72, v72, v19
  v_perm_b32 v36, v73, v73, v16
  v_perm_b32 v37, v73, v73, v17
  v_perm_b32 v38, v73, v73, v18
  v_perm_b32 v39, v73, v73, v19
  v_perm_b32 v40, v74, v74, v16
  v_perm_b32 v41, v74, v74, v17
  v_perm_b32 v42, v74, v74, v18
  v_perm_b32 v43, v74, v74, v19
  v_perm_b32 v44, v75, v75, v16
  v_perm_b32 v45, v75, v75, v17
  v_perm_b32 v46, v75, v75, v18
  v_perm_b32 v47, v75, v75, v19
  v_perm_b32 v48, v76, v76, v16
  v_perm_b32 v49, v76, v76, v17
  v_perm_b32 v50, v76, v76, v18
  v_perm_b32 v51, v76, v76, v19
  s_waitcnt vmcnt(13)
  v_mfma_f32_16x16x32_bf16 v[24:27], v[32:35], v[96:99], 0
  s_waitcnt vmcnt(12)
  v_mfma_f32_16x16x32_bf16 v[24:27], v[36:39], v[100:103], v[24:27]
  s_waitcnt vmcnt(11)
  v_mfma_f32_16x16x32_bf16 v[24:27], v[40:43], v[104:107], v[24:27]
  s_waitcnt vmcnt(10)
  v_mfma_f32_16x16x32_bf16 v[24:27], v[44:47], v[108:111], v[24:27]
  s_waitcnt vmcnt(9)
  v_mfma_f32_16x16x32_bf16 v[24:27], v[48:51], v[112:115], v[24:27]
  s_waitcnt vmcnt(8)
  s_mov_b32 s68, 1664525
  v_mul_lo_u32 v15, v15, s68
  v_add_u32 v15, 1013904223, v15
  v_bfe_u32 v44, v3, 2, 1
  v_lshlrev_b32 v44, 4, v44
  v_lshrrev_b32 v44, v44, v15
  v_lshrrev_b32 v45, 4, v44
  v_lshrrev_b32 v46, 8, v44
  v_lshrrev_b32 v47, 12, v44
  s_mov_b32 exec_hi, 0
  ds_write_b128 v60, v[24:27] offset:1280
  s_waitcnt lgkmcnt(0)
  s_barrier
  ds_read_b128 v[40:43], v61 offset:1280
  s_waitcnt lgkmcnt(0)
  v_add_f32_dpp v40, v40, v40 quad_perm:[1,0,3,2] row_mask:0xf bank_mask:0xf
  v_add_f32_dpp v41, v41, v41 quad_perm:[1,0,3,2] row_mask:0xf bank_mask:0xf
  v_add_f32_dpp v42, v42, v42 quad_perm:[1,0,3,2] row_mask:0xf bank_mask:0xf
  v_add_f32_dpp v43, v43, v43 quad_perm:[1,0,3,2] row_mask:0xf bank_mask:0xf
  v_add_f32_dpp v40, v40, v40 quad_perm:[2,3,0,1] row_mask:0xf bank_mask:0xf
  v_add_f32_dpp v41, v41, v41 quad_perm:[2,3,0,1] row_mask:0xf bank_mask:0xf
  v_add_f32_dpp v42, v42, v42 quad_perm:[2,3,0,1] row_mask:0xf bank_mask:0xf
  v_add_f32_dpp v43, v43, v43 quad_perm:[2,3,0,1] row_mask:0xf bank_mask:0xf
  s_mov_b32 exec_lo, 0x11111111
  v_bfi_b32 v40, 15, v44, v40
  v_bfi_b32 v41, 15, v45, v41
  v_bfi_b32 v42, 15, v46, v42
  v_bfi_b32 v43, 15, v47, v43
  buffer_store_dwordx4 v[40:43], v62, s[52:55], s100 offen
  s_mov_b64 exec, -1
  s_add_u32 s70, s65, 196608
  buffer_load_dwordx4 v[152:155], v5, s[32:35], s70 offen offset:0 nt
  s_add_u32 s70, s65, 229376
  buffer_load_dwordx4 v[156:159], v5, s[32:35], s70 offen offset:0 nt
  v_perm_b32 v96, v77, v77, v16
  v_perm_b32 v97, v77, v77, v17
  v_perm_b32 v98, v77, v77, v18
  v_perm_b32 v99, v77, v77, v19
  v_perm_b32 v100, v78, v78, v16
  v_perm_b32 v101, v78, v78, v17
  v_perm_b32 v102, v78, v78, v18
  v_perm_b32 v103, v78, v78, v19
  v_perm_b32 v104, v79, v79, v16
  v_perm_b32 v105, v79, v79, v17
  v_perm_b32 v106, v79, v79, v18
  v_perm_b32 v107, v79, v79, v19
  v_bfe_u32 v92, v3, 0, 1
  v_lshlrev_b32 v92, 4, v92
  v_lshrrev_b32 v92, v92, v15
  v_lshrrev_b32 v93, 4, v92
  v_lshrrev_b32 v94, 8, v92
  v_lshrrev_b32 v95, 12, v92
  s_lshl_b32 s3, s26, 10
  v_add_u32 v54, s3, v8
  s_mov_b32 s73, 0
  v_lshlrev_b32 v60, 3, v3
  v_lshlrev_b32 v61, 4, v1
  s_waitcnt vmcnt(8)
  buffer_load_dwordx4 v[116:119], v7, s[44:47], s67 offen nt
  s_add_u32 s67, s67, 110592
  s_waitcnt vmcnt(7)
  buffer_load_dwordx4 v[120:123], v7, s[44:47], s67 offen nt
  s_add_u32 s67, s67, 110592
  s_waitcnt vmcnt(7)
  buffer_load_dwordx4 v[224:227], v80, s[52:55], 0 offen sc1
  buffer_load_dwordx4 v[124:127], v7, s[60:63], s67 offen nt
  s_waitcnt vmcnt(8)
  buffer_load_dwordx4 v[160:163], v5, s[36:39], s65 offen offset:0 nt
  s_waitcnt vmcnt(8)
  buffer_load_dwordx4 v[228:231], v80, s[52:55], 0 offen sc1
  s_add_u32 s70, s65, 32768
  buffer_load_dwordx4 v[164:167], v5, s[36:39], s70 offen offset:0 nt
  s_waitcnt vmcnt(8)
  s_add_u32 s70, s65, 65536
  buffer_load_dwordx4 v[168:171], v5, s[36:39], s70 offen offset:0 nt
  buffer_load_dwordx4 v[232:235], v80, s[52:55], 0 offen sc1
  s_waitcnt vmcnt(9)
  s_add_u32 s70, s65, 98304
  buffer_load_dwordx4 v[172:175], v5, s[36:39], s70 offen offset:0 nt
  buffer_load_dwordx4 v[236:239], v80, s[52:55], 0 offen sc1
  s_waitcnt vmcnt(8)
  s_add_u32 s70, s65, 131072
  buffer_load_dwordx4 v[176:179], v5, s[36:39], s70 offen offset:0 nt
  v_xor_b32 v52, v224, v92
  v_bitop3_b32 v52, v225, v93, v52 bitop3:0xbe
  v_bitop3_b32 v52, v226, v94, v52 bitop3:0xbe
  v_bitop3_b32 v52, v227, v95, v52 bitop3:0xbe
  v_and_b32 v52, 15, v52
  v_cmp_ne_u32 vcc, 0, v52
  s_cbranch_vccnz L_q0
L_qw:
  ds_write_b128 v54, v[224:227] offset:13888
L_qok:
  s_waitcnt lgkmcnt(0)
  s_barrier
  ds_read_b64 v[40:41], v60 offset:13888
  ds_read_b64 v[42:43], v60 offset:14400
  ds_read_b64 v[44:45], v60 offset:14912
  ds_read_b64 v[46:47], v60 offset:15424
  ds_read_b64 v[48:49], v60 offset:15936
  ds_read_b64 v[50:51], v60 offset:16448
  ds_read_b64 v[52:53], v60 offset:16960
  ds_read_b64 v[54:55], v60 offset:17472
  s_cmp_ge_u32 s73, 1
  s_cbranch_scc1 L_skipf1
  s_add_u32 s70, s65, 163840
  buffer_load_dwordx4 v[180:183], v5, s[36:39], s70 offen offset:0 nt
  s_add_u32 s70, s65, 196608
  buffer_load_dwordx4 v[184:187], v5, s[36:39], s70 offen offset:0 nt
L_skipf1:
  s_cmp_ge_u32 s73, 2
  s_cbranch_scc1 L_skipf2
  s_add_u32 s70, s65, 229376
  buffer_load_dwordx4 v[188:191], v5, s[36:39], s70 offen offset:0 nt
  buffer_load_dwordx4 v[192:195], v6, s[48:51], s66 offen offset:0 nt
L_skipf2:
  s_cmp_ge_u32 s73, 3
  s_cbranch_scc1 L_skipf3
  buffer_load_dwordx4 v[196:199], v6, s[48:51], s66 offen offset:1280 nt
L_skipf3:
  s_waitcnt lgkmcnt(6)
  v_pk_add_f32 v[40:41], v[40:41], v[42:43]
  s_waitcnt lgkmcnt(4)
  v_pk_add_f32 v[44:45], v[44:45], v[46:47]
  s_waitcnt lgkmcnt(2)
  v_pk_add_f32 v[48:49], v[48:49], v[50:51]
  v_pk_add_f32 v[40:41], v[40:41], v[44:45]
  s_waitcnt lgkmcnt(0)
  v_pk_add_f32 v[52:53], v[52:53], v[54:55]
  v_pk_add_f32 v[48:49], v[48:49], v[52:53]
  v_pk_add_f32 v[40:41], v[40:41], v[48:49]
  v_cvt_pk_bf16_f32 v40, v40, v41
  ds_write_b32 v9, v40 offset:5376
  s_waitcnt lgkmcnt(0)
  ds_read_b128 v[56:59], v61 offset:5376
  s_cmp_eq_u32 s73, 9
  s_cbranch_scc1 L_sk_qs
  buffer_load_dwordx4 v[200:203], v6, s[48:51], s66 offen offset:2560 nt
  buffer_load_dwordx4 v[204:207], v6, s[48:51], s66 offen offset:3840 nt
L_sk_qs:
  s_waitcnt vmcnt(19) lgkmcnt(0)
  v_dot2_f32_bf16 v40, v128, v56, 0
  v_dot2_f32_bf16 v41, v132, v56, 0
  v_dot2_f32_bf16 v42, v136, v56, 0
  v_dot2_f32_bf16 v43, v140, v56, 0
  v_dot2_f32_bf16 v44, v144, v56, 0
  v_dot2_f32_bf16 v45, v148, v56, 0
  v_dot2_f32_bf16 v46, v152, v56, 0
  v_dot2_f32_bf16 v47, v156, v56, 0
  v_dot2_f32_bf16 v40, v129, v57, v40
  v_dot2_f32_bf16 v41, v133, v57, v41
  v_dot2_f32_bf16 v42, v137, v57, v42
  v_dot2_f32_bf16 v43, v141, v57, v43
  v_dot2_f32_bf16 v44, v145, v57, v44
  v_dot2_f32_bf16 v45, v149, v57, v45
  v_dot2_f32_bf16 v46, v153, v57, v46
  v_dot2_f32_bf16 v47, v157, v57, v47
  v_dot2_f32_bf16 v40, v130, v58, v40
  v_dot2_f32_bf16 v41, v134, v58, v41
  v_dot2_f32_bf16 v42, v138, v58, v42
  v_dot2_f32_bf16 v43, v142, v58, v43
  v_dot2_f32_bf16 v44, v146, v58, v44
  v_dot2_f32_bf16 v45, v150, v58, v45
  v_dot2_f32_bf16 v46, v154, v58, v46
  v_dot2_f32_bf16 v47, v158, v58, v47
  v_dot2_f32_bf16 v40, v131, v59, v40
  v_dot2_f32_bf16 v41, v135, v59, v41
  v_dot2_f32_bf16 v42, v139, v59, v42
  v_dot2_f32_bf16 v43, v143, v59, v43
  v_dot2_f32_bf16 v44, v147, v59, v44
  v_dot2_f32_bf16 v45, v151, v59, v45
  v_dot2_f32_bf16 v46, v155, v59, v46
  v_dot2_f32_bf16 v47, v159, v59, v47
  s_cmp_eq_u32 s73, 9
  s_cbranch_scc1 L_sk_dot
  buffer_load_dwordx4 v[208:211], v6, s[48:51], s71 offen offset:0 nt
L_sk_dot:
  v_add_f32_dpp v48, v40, v40 row_ror:8 row_mask:0xf bank_mask:0x3
  v_add_f32_dpp v49, v41, v41 row_ror:8 row_mask:0xf bank_mask:0x3
  v_add_f32_dpp v50, v42, v42 row_ror:8 row_mask:0xf bank_mask:0x3
  v_add_f32_dpp v51, v43, v43 row_ror:8 row_mask:0xf bank_mask:0x3
  v_add_f32_dpp v48, v44, v44 row_ror:8 row_mask:0xf bank_mask:0xc
  v_add_f32_dpp v49, v45, v45 row_ror:8 row_mask:0xf bank_mask:0xc
  v_add_f32_dpp v50, v46, v46 row_ror:8 row_mask:0xf bank_mask:0xc
  v_add_f32_dpp v51, v47, v47 row_ror:8 row_mask:0xf bank_mask:0xc
  v_add_f32_dpp v48, v48, v48 row_half_mirror row_mask:0xf bank_mask:0xf
  v_add_f32_dpp v49, v49, v49 row_half_mirror row_mask:0xf bank_mask:0xf
  v_add_f32_dpp v50, v50, v50 row_half_mirror row_mask:0xf bank_mask:0xf
  v_add_f32_dpp v51, v51, v51 row_half_mirror row_mask:0xf bank_mask:0xf
  v_add_f32_dpp v48, v48, v48 quad_perm:[2,3,0,1] row_mask:0xf bank_mask:0xf
  v_add_f32_dpp v49, v49, v49 quad_perm:[2,3,0,1] row_mask:0xf bank_mask:0xf
  v_add_f32_dpp v50, v50, v50 quad_perm:[2,3,0,1] row_mask:0xf bank_mask:0xf
  v_add_f32_dpp v51, v51, v51 quad_perm:[2,3,0,1] row_mask:0xf bank_mask:0xf
  v_add_f32_dpp v48, v48, v48 quad_perm:[1,0,3,2] row_mask:0xf bank_mask:0xf
  v_add_f32_dpp v49, v49, v49 quad_perm:[1,0,3,2] row_mask:0xf bank_mask:0xf
  v_add_f32_dpp v50, v50, v50 quad_perm:[1,0,3,2] row_mask:0xf bank_mask:0xf
  v_add_f32_dpp v51, v51, v51 quad_perm:[1,0,3,2] row_mask:0xf bank_mask:0xf
  v_cvt_pk_bf16_f32 v44, v48, v49
  v_cvt_pk_bf16_f32 v45, v50, v51
  v_lshlrev_b32 v48, 16, v44
  v_and_b32 v49, 0xffff0000, v44
  v_lshlrev_b32 v50, 16, v45
  v_and_b32 v51, 0xffff0000, v45
  v_mul_f32 v48, 0x3db504f3, v48
  v_mul_f32 v49, 0x3db504f3, v49
  v_mul_f32 v50, 0x3db504f3, v50
  v_mul_f32 v51, 0x3db504f3, v51
  v_cvt_pk_bf16_f32 v44, v48, v49
  v_cvt_pk_bf16_f32 v45, v50, v51
  v_lshlrev_b32 v48, 16, v44
  v_and_b32 v49, 0xffff0000, v44
  v_lshlrev_b32 v50, 16, v45
  v_and_b32 v51, 0xffff0000, v45
  v_max3_f32 v63, v48, v49, v50
  v_max_f32 v63, v63, v51
  s_nop 1
  v_max_f32_dpp v63, v63, v63 row_ror:8 row_mask:0xf bank_mask:0xf
  v_mov_b32 v54, v63
  s_nop 1
  v_permlane16_swap_b32 v63, v54
  v_max_f32 v63, v63, v54
  v_mov_b32 v54, v63
  s_nop 1
  v_permlane32_swap_b32 v63, v54
  v_max_f32 v63, v63, v54
  s_cmp_eq_u32 s73, 9
  s_cbranch_scc1 L_sk_s
  buffer_load_dwordx4 v[212:215], v6, s[48:51], s71 offen offset:1280 nt
L_sk_s:
  v_mul_f32 v57, 0xbfb8aa3b, v63
  v_fma_f32 v48, v48, s27, v57
  v_fma_f32 v49, v49, s27, v57
  v_fma_f32 v50, v50, s27, v57
  v_fma_f32 v51, v51, s27, v57
  v_exp_f32 v48, v48
  v_exp_f32 v49, v49
  v_exp_f32 v50, v50
  v_exp_f32 v51, v51
  s_nop 0
  v_cvt_pk_bf16_f32 v44, v48, v49
  v_cvt_pk_bf16_f32 v45, v50, v51
  v_add_f32 v53, v48, v49
  v_add_f32 v57, v50, v51
  v_add_f32 v53, v53, v57
  s_cmp_eq_u32 s73, 9
  s_cbranch_scc1 L_sk_e
  buffer_load_dwordx4 v[216:219], v6, s[48:51], s71 offen offset:2560 nt
L_sk_e:
  v_perm_b32 v32, v44, v44, v16
  v_perm_b32 v33, v44, v44, v17
  v_perm_b32 v34, v44, v44, v18
  v_perm_b32 v35, v44, v44, v19
  v_perm_b32 v36, v44, v44, v20
  v_perm_b32 v37, v44, v44, v21
  v_perm_b32 v38, v44, v44, v22
  v_perm_b32 v39, v44, v44, v23
  v_perm_b32 v40, v45, v45, v16
  v_perm_b32 v41, v45, v45, v17
  v_perm_b32 v42, v45, v45, v18
  v_perm_b32 v43, v45, v45, v19
  v_perm_b32 v48, v45, v45, v20
  v_perm_b32 v49, v45, v45, v21
  v_perm_b32 v50, v45, v45, v22
  v_perm_b32 v51, v45, v45, v23
  s_nop 1
  v_add_f32_dpp v53, v53, v53 row_ror:8 row_mask:0xf bank_mask:0xf
  v_mov_b32 v54, v53
  s_nop 1
  v_permlane16_swap_b32 v53, v54
  v_add_f32 v53, v53, v54
  v_mov_b32 v54, v53
  s_nop 1
  v_permlane32_swap_b32 v53, v54
  v_add_f32 v53, v53, v54
  s_lshl_b32 s3, s26, 3
  v_mov_b32 v55, s3
  ds_write_b32 v55, v63 offset:9728
  ds_write_b32 v55, v53 offset:9732
  v_mov_b32 v62, 0
  v_and_b32 v61, 6, v82
  v_lshlrev_b32 v61, 2, v61
  v_lshl_add_u32 v57, v82, 8, v87
  s_waitcnt vmcnt(21)
  v_mfma_f32_16x16x32_bf16 v[108:111], v[96:99], v[116:119], 0
  s_waitcnt vmcnt(20)
  v_mfma_f32_16x16x32_bf16 v[108:111], v[100:103], v[120:123], v[108:111]
  s_waitcnt vmcnt(18)
  v_mfma_f32_16x16x32_bf16 v[108:111], v[104:107], v[124:127], v[108:111]
  s_cmp_eq_u32 s26, 0
  s_cselect_b32 s3, 0x03030303, 0
  s_or_b32 s3, s3, 0x01010101
  s_nop 4
  s_mov_b32 exec_lo, 0xff00ff
  s_mov_b32 exec_hi, 0xff00ff00
  ds_write_b128 v13, v[108:111] offset:3328
  s_mov_b64 exec, -1
  s_waitcnt vmcnt(17)
  v_mfma_f32_16x16x32_bf16 v[24:27], v[32:35], v[160:163], 0
  s_waitcnt vmcnt(15)
  v_mfma_f32_16x16x32_bf16 v[24:27], v[36:39], v[164:167], v[24:27]
  s_cmp_eq_u32 s73, 9
  s_cbranch_scc1 L_sk_pv1
  buffer_load_dwordx4 v[220:223], v6, s[48:51], s71 offen offset:3840 nt
L_sk_pv1:
  s_waitcnt vmcnt(15)
  v_mfma_f32_16x16x32_bf16 v[24:27], v[40:43], v[168:171], v[24:27]
  s_waitcnt vmcnt(13)
  v_mfma_f32_16x16x32_bf16 v[24:27], v[48:51], v[172:175], v[24:27]
  s_waitcnt vmcnt(11)
  v_mfma_f32_16x16x32_bf16 v[28:31], v[32:35], v[176:179], 0
  s_waitcnt vmcnt(10)
  v_mfma_f32_16x16x32_bf16 v[28:31], v[36:39], v[180:183], v[28:31]
  s_waitcnt vmcnt(9)
  v_mfma_f32_16x16x32_bf16 v[28:31], v[40:43], v[184:187], v[28:31]
  s_waitcnt vmcnt(8)
  v_mfma_f32_16x16x32_bf16 v[28:31], v[48:51], v[188:191], v[28:31]
  s_mov_b32 exec_hi, 0
  s_nop 2
  ds_write_b128 v12, v[24:27] offset:5632
  s_mov_b32 exec_lo, 0
  s_mov_b32 exec_hi, -1
  s_nop 0
  ds_write_b128 v12, v[28:31] offset:5632
  s_mov_b32 exec_lo, -1
  s_cmp_ge_u32 s25, s98
  s_waitcnt lgkmcnt(0)
  s_barrier
  ds_read_b128 v[48:51], v62 offset:9728
  ds_read_b128 v[32:35], v62 offset:9744
  ds_read_b64 v[44:45], v61 offset:9728
  ds_read_b128 v[40:43], v84 offset:5632
  ds_read_b128 v[36:39], v57 offset:3328
  s_waitcnt lgkmcnt(3)
  v_max3_f32 v63, v48, v50, v32
  v_max_f32 v63, v63, v34
  s_waitcnt lgkmcnt(2)
  v_sub_f32 v44, v44, v63
  v_mul_f32 v44, s27, v44
  v_exp_f32 v44, v44
  v_mul_f32 v45, 0.5, v45
  s_waitcnt lgkmcnt(1)
  v_mul_f32 v45, v45, v44
  v_mul_f32 v40, v40, v44
  v_mul_f32 v41, v41, v44
  v_mul_f32 v42, v42, v44
  v_mul_f32 v43, v43, v44
  v_add_f32_dpp v45, v45, v45 quad_perm:[1,0,3,2] row_mask:0xf bank_mask:0xf
  v_add_f32_dpp v40, v40, v40 quad_perm:[1,0,3,2] row_mask:0xf bank_mask:0xf
  v_add_f32_dpp v41, v41, v41 quad_perm:[1,0,3,2] row_mask:0xf bank_mask:0xf
  v_add_f32_dpp v42, v42, v42 quad_perm:[1,0,3,2] row_mask:0xf bank_mask:0xf
  v_add_f32_dpp v43, v43, v43 quad_perm:[1,0,3,2] row_mask:0xf bank_mask:0xf
  v_add_f32_dpp v45, v45, v45 quad_perm:[2,3,0,1] row_mask:0xf bank_mask:0xf
  v_add_f32_dpp v40, v40, v40 quad_perm:[2,3,0,1] row_mask:0xf bank_mask:0xf
  v_add_f32_dpp v41, v41, v41 quad_perm:[2,3,0,1] row_mask:0xf bank_mask:0xf
  v_add_f32_dpp v42, v42, v42 quad_perm:[2,3,0,1] row_mask:0xf bank_mask:0xf
  v_add_f32_dpp v43, v43, v43 quad_perm:[2,3,0,1] row_mask:0xf bank_mask:0xf
  v_add_f32_dpp v45, v45, v45 row_half_mirror row_mask:0xf bank_mask:0xf
  v_add_f32_dpp v40, v40, v40 row_half_mirror row_mask:0xf bank_mask:0xf
  v_add_f32_dpp v41, v41, v41 row_half_mirror row_mask:0xf bank_mask:0xf
  v_add_f32_dpp v42, v42, v42 row_half_mirror row_mask:0xf bank_mask:0xf
  v_add_f32_dpp v43, v43, v43 row_half_mirror row_mask:0xf bank_mask:0xf
  s_mov_b32 exec_lo, 0x2020202
  s_mov_b32 exec_hi, 0x2020202
  v_mov_b32 v40, v63
  v_mov_b32 v41, v45
  v_mov_b32 v42, s99
  s_mov_b32 exec_lo, s3
  s_mov_b32 exec_hi, s3
  v_perm_b32 v40, v40, v15, s6
  v_perm_b32 v41, v41, v15, s7
  v_perm_b32 v42, v42, v15, s8
  v_perm_b32 v43, v43, v15, s9
  buffer_store_dwordx4 v[40:43], v86, s[52:55], s101 offen
  s_mov_b64 exec, -1
  s_waitcnt lgkmcnt(0)
  v_add_f32_dpp v36, v36, v36 quad_perm:[1,0,3,2] row_mask:0xf bank_mask:0xf
  v_add_f32_dpp v37, v37, v37 quad_perm:[1,0,3,2] row_mask:0xf bank_mask:0xf
  v_add_f32_dpp v38, v38, v38 quad_perm:[1,0,3,2] row_mask:0xf bank_mask:0xf
  v_add_f32_dpp v39, v39, v39 quad_perm:[1,0,3,2] row_mask:0xf bank_mask:0xf
  v_add_f32_dpp v36, v36, v36 quad_perm:[2,3,0,1] row_mask:0xf bank_mask:0xf
  v_add_f32_dpp v37, v37, v37 quad_perm:[2,3,0,1] row_mask:0xf bank_mask:0xf
  v_add_f32_dpp v38, v38, v38 quad_perm:[2,3,0,1] row_mask:0xf bank_mask:0xf
  v_add_f32_dpp v39, v39, v39 quad_perm:[2,3,0,1] row_mask:0xf bank_mask:0xf
  v_add_f32_dpp v36, v36, v36 row_half_mirror row_mask:0xf bank_mask:0xf
  v_add_f32_dpp v37, v37, v37 row_half_mirror row_mask:0xf bank_mask:0xf
  v_add_f32_dpp v38, v38, v38 row_half_mirror row_mask:0xf bank_mask:0xf
  v_add_f32_dpp v39, v39, v39 row_half_mirror row_mask:0xf bank_mask:0xf
  s_mov_b32 exec_lo, 0x1010101
  s_mov_b32 exec_hi, 0x0
  v_perm_b32 v36, v36, v15, s6
  v_perm_b32 v37, v37, v15, s7
  v_perm_b32 v38, v38, v15, s8
  v_perm_b32 v39, v39, v15, s9
  buffer_store_dwordx4 v[36:39], v87, s[52:55], s101 offen offset:512
  s_mov_b64 exec, -1
  s_cbranch_scc1 L_red
  s_sub_u32 s68, s25, 5
  s_cmp_lt_u32 s68, 2
  s_cselect_b32 s73, 0x10101010, 0
  s_or_b32 s73, s73, 0x01010101
  s_waitcnt vmcnt(3)
  s_movk_i32 s3, 32
L_t1:
  buffer_load_dwordx4 v[56:59], v81, s[52:55], 0 offen offset:768 sc1
  buffer_load_dwordx4 v[48:51], v14, s[52:55], 0 offen sc1
  s_sub_u32 s3, s3, 1
  s_cbranch_scc1 L_p1s
  s_waitcnt vmcnt(1)
  v_perm_b32 v52, v57, v56, s10
  v_perm_b32 v53, v59, v58, s10
  v_perm_b32 v52, v53, v52, s11
  v_cmp_ne_u32 s[4:5], v52, v15
  v_and_b32 v55, 0xffff0000, v56
  s_waitcnt vmcnt(0)
  v_perm_b32 v52, v49, v48, s10
  v_perm_b32 v53, v51, v50, s10
  v_perm_b32 v52, v53, v52, s11
  v_cmp_ne_u32 vcc, v52, v15
  s_or_b64 vcc, vcc, s[4:5]
  s_cbranch_vccnz L_t1
L_p1x:
  s_cmp_ge_u32 s25, 5
  s_cbranch_scc1 L_hpath
  v_max_f32_dpp v53, v55, v55 quad_perm:[1,0,3,2] row_mask:0xf bank_mask:0xf
  s_nop 1
  v_max_f32_dpp v53, v53, v53 quad_perm:[2,3,0,1] row_mask:0xf bank_mask:0xf
  s_nop 1
  v_max_f32_dpp v53, v53, v53 row_half_mirror row_mask:0xf bank_mask:0xf
  v_sub_f32 v54, v55, v53
  v_mul_f32 v54, s27, v54
  v_exp_f32 v54, v54
  s_nop 0
  v_mul_f32 v53, v54, v57
  v_mul_f32 v48, v54, v48
  v_mul_f32 v49, v54, v49
  v_mul_f32 v50, v54, v50
  v_mul_f32 v51, v54, v51
  v_add_f32_dpp v53, v53, v53 quad_perm:[1,0,3,2] row_mask:0xf bank_mask:0xf
  v_add_f32_dpp v48, v48, v48 quad_perm:[1,0,3,2] row_mask:0xf bank_mask:0xf
  v_add_f32_dpp v49, v49, v49 quad_perm:[1,0,3,2] row_mask:0xf bank_mask:0xf
  v_add_f32_dpp v50, v50, v50 quad_perm:[1,0,3,2] row_mask:0xf bank_mask:0xf
  v_add_f32_dpp v51, v51, v51 quad_perm:[1,0,3,2] row_mask:0xf bank_mask:0xf
  v_add_f32_dpp v53, v53, v53 quad_perm:[2,3,0,1] row_mask:0xf bank_mask:0xf
  v_add_f32_dpp v48, v48, v48 quad_perm:[2,3,0,1] row_mask:0xf bank_mask:0xf
  v_add_f32_dpp v49, v49, v49 quad_perm:[2,3,0,1] row_mask:0xf bank_mask:0xf
  v_add_f32_dpp v50, v50, v50 quad_perm:[2,3,0,1] row_mask:0xf bank_mask:0xf
  v_add_f32_dpp v51, v51, v51 quad_perm:[2,3,0,1] row_mask:0xf bank_mask:0xf
  v_add_f32_dpp v53, v53, v53 row_half_mirror row_mask:0xf bank_mask:0xf
  v_rcp_f32 v53, v53
  v_add_f32_dpp v48, v48, v48 row_half_mirror row_mask:0xf bank_mask:0xf
  v_add_f32_dpp v49, v49, v49 row_half_mirror row_mask:0xf bank_mask:0xf
  v_add_f32_dpp v50, v50, v50 row_half_mirror row_mask:0xf bank_mask:0xf
  v_add_f32_dpp v51, v51, v51 row_half_mirror row_mask:0xf bank_mask:0xf
  v_mul_f32 v48, v53, v48
  v_mul_f32 v49, v53, v49
  v_mul_f32 v50, v53, v50
  v_mul_f32 v51, v53, v51
  v_cvt_pk_bf16_f32 v44, v48, v49
  v_cvt_pk_bf16_f32 v45, v50, v51
  v_perm_b32 v32, v44, v44, v16
  v_perm_b32 v33, v44, v44, v17
  v_perm_b32 v34, v44, v44, v18
  v_perm_b32 v35, v44, v44, v19
  v_perm_b32 v36, v44, v44, v20
  v_perm_b32 v37, v44, v44, v21
  v_perm_b32 v38, v44, v44, v22
  v_perm_b32 v39, v44, v44, v23
  s_waitcnt vmcnt(4)
  v_mfma_f32_16x16x32_bf16 v[24:27], v[32:35], v[192:195], 0
  v_mfma_f32_16x16x32_bf16 v[28:31], v[32:35], v[208:211], 0
  v_perm_b32 v40, v45, v45, v16
  v_perm_b32 v41, v45, v45, v17
  v_perm_b32 v42, v45, v45, v18
  v_perm_b32 v43, v45, v45, v19
  v_mfma_f32_16x16x32_bf16 v[24:27], v[36:39], v[196:199], v[24:27]
  v_mfma_f32_16x16x32_bf16 v[28:31], v[36:39], v[212:215], v[28:31]
  v_perm_b32 v48, v45, v45, v20
  v_perm_b32 v49, v45, v45, v21
  v_perm_b32 v50, v45, v45, v22
  v_perm_b32 v51, v45, v45, v23
  v_mfma_f32_16x16x32_bf16 v[24:27], v[40:43], v[200:203], v[24:27]
  v_mfma_f32_16x16x32_bf16 v[28:31], v[40:43], v[216:219], v[28:31]
  v_mfma_f32_16x16x32_bf16 v[24:27], v[48:51], v[204:207], v[24:27]
  v_mfma_f32_16x16x32_bf16 v[28:31], v[48:51], v[220:223], v[28:31]
  v_and_b32 v58, 0xffffff00, v58
  v_cmp_ne_u32 s[22:23], s99, v58
  s_nop 3
  s_mov_b32 exec_hi, 0
  ds_write_b128 v12, v[24:27] offset:9792
  s_mov_b32 exec_lo, 0
  s_mov_b32 exec_hi, -1
  ds_write_b128 v12, v[28:31] offset:9792
  s_mov_b32 exec_lo, -1
  s_waitcnt lgkmcnt(0)
  s_barrier
  ds_read_b128 v[40:43], v84 offset:9792
  s_cmp_eq_u64 s[22:23], 0
  s_waitcnt lgkmcnt(0)
  v_add_f32_dpp v40, v40, v40 quad_perm:[1,0,3,2] row_mask:0xf bank_mask:0xf
  v_add_f32_dpp v41, v41, v41 quad_perm:[1,0,3,2] row_mask:0xf bank_mask:0xf
  v_add_f32_dpp v42, v42, v42 quad_perm:[1,0,3,2] row_mask:0xf bank_mask:0xf
  v_add_f32_dpp v43, v43, v43 quad_perm:[1,0,3,2] row_mask:0xf bank_mask:0xf
  v_add_f32_dpp v40, v40, v40 quad_perm:[2,3,0,1] row_mask:0xf bank_mask:0xf
  v_add_f32_dpp v41, v41, v41 quad_perm:[2,3,0,1] row_mask:0xf bank_mask:0xf
  v_add_f32_dpp v42, v42, v42 quad_perm:[2,3,0,1] row_mask:0xf bank_mask:0xf
  v_add_f32_dpp v43, v43, v43 quad_perm:[2,3,0,1] row_mask:0xf bank_mask:0xf
  v_add_f32_dpp v40, v40, v40 row_half_mirror row_mask:0xf bank_mask:0xf
  v_add_f32_dpp v41, v41, v41 row_half_mirror row_mask:0xf bank_mask:0xf
  v_add_f32_dpp v42, v42, v42 row_half_mirror row_mask:0xf bank_mask:0xf
  v_add_f32_dpp v43, v43, v43 row_half_mirror row_mask:0xf bank_mask:0xf
  s_mov_b32 exec_lo, s73
  s_mov_b32 exec_hi, s73
  v_perm_b32 v40, v40, v15, s6
  v_perm_b32 v41, v41, v15, s7
  v_perm_b32 v42, v42, v15, s8
  v_perm_b32 v43, v43, v15, s9
  buffer_store_dwordx4 v[40:43], v85, s[52:55], s72 offen sc1
  s_cbranch_scc0 L_em
  s_endpgm
L_hpath:
  v_add_f32_dpp v48, v48, v48 quad_perm:[1,0,3,2] row_mask:0xf bank_mask:0xf
  v_add_f32_dpp v49, v49, v49 quad_perm:[1,0,3,2] row_mask:0xf bank_mask:0xf
  v_add_f32_dpp v50, v50, v50 quad_perm:[1,0,3,2] row_mask:0xf bank_mask:0xf
  v_add_f32_dpp v51, v51, v51 quad_perm:[1,0,3,2] row_mask:0xf bank_mask:0xf
  v_add_f32_dpp v48, v48, v48 quad_perm:[2,3,0,1] row_mask:0xf bank_mask:0xf
  v_add_f32_dpp v49, v49, v49 quad_perm:[2,3,0,1] row_mask:0xf bank_mask:0xf
  v_add_f32_dpp v50, v50, v50 quad_perm:[2,3,0,1] row_mask:0xf bank_mask:0xf
  v_add_f32_dpp v51, v51, v51 quad_perm:[2,3,0,1] row_mask:0xf bank_mask:0xf
  v_add_f32_dpp v48, v48, v48 row_half_mirror row_mask:0xf bank_mask:0xf
  v_add_f32_dpp v49, v49, v49 row_half_mirror row_mask:0xf bank_mask:0xf
  v_add_f32_dpp v50, v50, v50 row_half_mirror row_mask:0xf bank_mask:0xf
  v_add_f32_dpp v51, v51, v51 row_half_mirror row_mask:0xf bank_mask:0xf
  v_cvt_pk_bf16_f32 v44, v48, v49
  v_cvt_pk_bf16_f32 v45, v50, v51
  v_lshlrev_b32 v48, 16, v44
  v_and_b32 v49, 0xffff0000, v44
  v_lshlrev_b32 v50, 16, v45
  v_and_b32 v51, 0xffff0000, v45
  v_mul_f32 v52, 0xbfb8aa3b, v48
  v_mul_f32 v53, 0xbfb8aa3b, v49
  v_mul_f32 v54, 0xbfb8aa3b, v50
  v_mul_f32 v55, 0xbfb8aa3b, v51
  v_exp_f32 v52, v52
  v_exp_f32 v53, v53
  v_exp_f32 v54, v54
  v_exp_f32 v55, v55
  v_add_f32 v52, 1.0, v52
  v_add_f32 v53, 1.0, v53
  v_add_f32 v54, 1.0, v54
  v_add_f32 v55, 1.0, v55
  v_rcp_f32 v52, v52
  v_rcp_f32 v53, v53
  v_rcp_f32 v54, v54
  v_rcp_f32 v55, v55
  v_mul_f32 v48, v48, v52
  v_mul_f32 v49, v49, v53
  v_mul_f32 v50, v50, v54
  v_mul_f32 v51, v51, v55
  v_cvt_pk_bf16_f32 v44, v48, v49
  v_cvt_pk_bf16_f32 v45, v50, v51
  v_perm_b32 v32, v44, v44, v16
  v_perm_b32 v33, v44, v44, v17
  v_perm_b32 v34, v44, v44, v18
  v_perm_b32 v35, v44, v44, v19
  v_perm_b32 v36, v44, v44, v20
  v_perm_b32 v37, v44, v44, v21
  v_perm_b32 v38, v44, v44, v22
  v_perm_b32 v39, v44, v44, v23
  s_waitcnt vmcnt(4)
  v_mfma_f32_16x16x32_bf16 v[24:27], v[32:35], v[192:195], 0
  v_mfma_f32_16x16x32_bf16 v[28:31], v[32:35], v[208:211], 0
  v_perm_b32 v40, v45, v45, v16
  v_perm_b32 v41, v45, v45, v17
  v_perm_b32 v42, v45, v45, v18
  v_perm_b32 v43, v45, v45, v19
  v_mfma_f32_16x16x32_bf16 v[24:27], v[36:39], v[196:199], v[24:27]
  v_mfma_f32_16x16x32_bf16 v[28:31], v[36:39], v[212:215], v[28:31]
  v_perm_b32 v48, v45, v45, v20
  v_perm_b32 v49, v45, v45, v21
  v_perm_b32 v50, v45, v45, v22
  v_perm_b32 v51, v45, v45, v23
  v_mfma_f32_16x16x32_bf16 v[24:27], v[40:43], v[200:203], v[24:27]
  v_mfma_f32_16x16x32_bf16 v[28:31], v[40:43], v[216:219], v[28:31]
  v_mfma_f32_16x16x32_bf16 v[24:27], v[48:51], v[204:207], v[24:27]
  v_mfma_f32_16x16x32_bf16 v[28:31], v[48:51], v[220:223], v[28:31]
  v_and_b32 v58, 0xffffff00, v58
  v_cmp_ne_u32 s[22:23], s99, v58
  s_nop 3
  s_mov_b32 exec_hi, 0
  ds_write_b128 v12, v[24:27] offset:9792
  s_mov_b32 exec_lo, 0
  s_mov_b32 exec_hi, -1
  ds_write_b128 v12, v[28:31] offset:9792
  s_mov_b32 exec_lo, -1
  s_waitcnt lgkmcnt(0)
  s_barrier
  ds_read_b128 v[40:43], v84 offset:9792
  s_cmp_eq_u64 s[22:23], 0
  s_waitcnt lgkmcnt(0)
  v_add_f32_dpp v40, v40, v40 quad_perm:[1,0,3,2] row_mask:0xf bank_mask:0xf
  v_add_f32_dpp v41, v41, v41 quad_perm:[1,0,3,2] row_mask:0xf bank_mask:0xf
  v_add_f32_dpp v42, v42, v42 quad_perm:[1,0,3,2] row_mask:0xf bank_mask:0xf
  v_add_f32_dpp v43, v43, v43 quad_perm:[1,0,3,2] row_mask:0xf bank_mask:0xf
  v_add_f32_dpp v40, v40, v40 quad_perm:[2,3,0,1] row_mask:0xf bank_mask:0xf
  v_add_f32_dpp v41, v41, v41 quad_perm:[2,3,0,1] row_mask:0xf bank_mask:0xf
  v_add_f32_dpp v42, v42, v42 quad_perm:[2,3,0,1] row_mask:0xf bank_mask:0xf
  v_add_f32_dpp v43, v43, v43 quad_perm:[2,3,0,1] row_mask:0xf bank_mask:0xf
  s_mov_b32 exec_lo, s73
  s_mov_b32 exec_hi, s73
  v_perm_b32 v40, v40, v15, s6
  v_perm_b32 v41, v41, v15, s7
  v_perm_b32 v42, v42, v15, s8
  v_perm_b32 v43, v43, v15, s9
  buffer_store_dwordx4 v[40:43], v85, s[52:55], s72 offen sc1
  s_cbranch_scc0 L_em
  s_endpgm
L_red:
  s_mov_b64 s[22:23], -1
  s_cmp_eq_u32 s26, 3
  s_cbranch_scc1 L_em
L_red2:
  s_sub_u32 s64, s25, 5
  s_mul_i32 s64, s64, 5
  s_add_u32 s64, s64, s97
  s_sub_u32 s64, s64, 27
  s_mul_i32 s64, s64, 3
  s_add_u32 s72, s64, s26
  s_cmp_ge_u32 s72, 40
  s_cbranch_scc1 L_done
L_red3:
  s_mov_b64 s[56:57], s[20:21]
  s_mov_b32 s58, 0x500
  s_mov_b32 s59, 0x20000
  v_and_b32 v42, 3, v3
  v_lshrrev_b32 v43, 2, v3
  v_lshlrev_b32 v75, 7, v43
  v_lshl_add_u32 v75, v42, 4, v75
  s_lshl_b32 s64, s72, 13
  s_add_u32 s64, s64, 397312
  v_add_u32 v75, s64, v75
  s_lshl_b32 s64, s72, 5
  v_lshl_add_u32 v74, v42, 3, s64
  buffer_load_dwordx2 v[76:77], v74, s[28:31], 0 offen
  v_and_b32 v44, 1, v2
  v_lshl_add_u32 v74, v44, 1, v74
  v_lshlrev_b32 v44, 4, v44
  v_sub_u32 v44, 16, v44
  v_mov_b32 v140, 0
  v_mov_b32 v141, 0
  v_mov_b32 v142, 0
  v_mov_b32 v143, 0
  s_waitcnt vmcnt(0)
  v_lshlrev_b32 v72, v44, v76
  v_lshlrev_b32 v73, v44, v77
  v_and_b32 v72, 0xffff0000, v72
  v_and_b32 v73, 0xffff0000, v73
  s_mov_b64 s[32:33], -1
  s_mov_b64 s[34:35], -1
  s_mov_b64 s[36:37], -1
  s_mov_b32 s38, -1
  s_mov_b32 s39, 0xfff
  s_mov_b32 s3, 262144
  s_movk_i32 s64, 4096
L_p2:
  s_mov_b64 exec, s[32:33]
  s_cbranch_execz L_p2s0
  buffer_load_dwordx4 v[128:131], v75, s[52:55], 0 offen offset:0 sc1
L_p2s0:
  s_mov_b64 exec, s[34:35]
  s_cbranch_execz L_p2s1
  buffer_load_dwordx4 v[132:135], v75, s[52:55], 0 offen offset:2048 sc1
L_p2s1:
  s_mov_b64 exec, s[36:37]
  s_cbranch_execz L_p2s2
  buffer_load_dwordx4 v[136:139], v75, s[52:55], s64 offen offset:0 sc1
L_p2s2:
  s_mov_b64 exec, s[38:39]
  s_cbranch_execz L_p2s3
  buffer_load_dwordx4 v[140:143], v75, s[52:55], s64 offen offset:2048 sc1
L_p2s3:
  s_sub_u32 s3, s3, 1
  s_cbranch_scc1 L_p2x
  s_waitcnt vmcnt(0)
  s_mov_b64 exec, s[32:33]
  v_perm_b32 v52, v129, v128, s10
  v_perm_b32 v53, v131, v130, s10
  v_perm_b32 v52, v53, v52, s11
  v_cmp_ne_u32 s[32:33], v52, v15
  s_mov_b64 exec, s[34:35]
  v_perm_b32 v52, v133, v132, s10
  v_perm_b32 v53, v135, v134, s10
  v_perm_b32 v52, v53, v52, s11
  v_cmp_ne_u32 s[34:35], v52, v15
  s_mov_b64 exec, s[36:37]
  v_perm_b32 v52, v137, v136, s10
  v_perm_b32 v53, v139, v138, s10
  v_perm_b32 v52, v53, v52, s11
  v_cmp_ne_u32 s[36:37], v52, v15
  s_mov_b64 exec, s[38:39]
  v_perm_b32 v52, v141, v140, s10
  v_perm_b32 v53, v143, v142, s10
  v_perm_b32 v52, v53, v52, s11
  v_cmp_ne_u32 s[38:39], v52, v15
  s_or_b64 s[4:5], s[32:33], s[34:35]
  s_or_b64 s[4:5], s[4:5], s[36:37]
  s_or_b64 s[4:5], s[4:5], s[38:39]
  s_cbranch_scc1 L_p2
L_p2x:
  s_mov_b64 exec, -1
  v_add_f32 v128, v128, v132
  v_add_f32 v129, v129, v133
  v_add_f32 v130, v130, v134
  v_add_f32 v131, v131, v135
  v_add_f32 v136, v136, v140
  v_add_f32 v137, v137, v141
  v_add_f32 v138, v138, v142
  v_add_f32 v139, v139, v143
  v_permlane32_swap_b32 v128, v136
  v_permlane32_swap_b32 v129, v137
  v_permlane32_swap_b32 v130, v138
  v_permlane32_swap_b32 v131, v139
  v_add_f32 v128, v128, v136
  v_add_f32 v129, v129, v137
  v_add_f32 v130, v130, v138
  v_add_f32 v131, v131, v139
  v_permlane16_swap_b32 v128, v129
  s_nop 0
  v_permlane16_swap_b32 v130, v131
  v_add_f32 v128, v128, v129
  v_add_f32 v130, v130, v131
  s_nop 0
  v_add_f32_dpp v128, v128, v128 row_ror:4 row_mask:0xf bank_mask:0xf
  v_add_f32_dpp v130, v130, v130 row_ror:4 row_mask:0xf bank_mask:0xf
  s_nop 0
  v_add_f32_dpp v128, v128, v128 row_ror:8 row_mask:0xf bank_mask:0xf
  v_add_f32_dpp v130, v130, v130 row_ror:8 row_mask:0xf bank_mask:0xf
  v_cvt_pk_bf16_f32 v128, v128, v130
  v_mov_b32 v129, v128
  s_nop 1
  v_permlane32_swap_b32 v128, v129
  v_lshlrev_b32 v136, 16, v128
  v_and_b32 v137, 0xffff0000, v128
  v_lshlrev_b32 v138, 16, v129
  v_and_b32 v139, 0xffff0000, v129
  v_add_f32 v136, v136, v72
  v_add_f32 v137, v137, v73
  v_cvt_pk_bf16_f32 v128, v136, v137
  v_lshlrev_b32 v136, 16, v128
  v_and_b32 v137, 0xffff0000, v128
  v_add_f32 v136, v136, v138
  v_add_f32 v137, v137, v139
  v_cvt_pk_bf16_f32 v128, v136, v137
  s_mov_b64 exec, 0x000f000f
  buffer_store_short v128, v74, s[56:59], 0 offen
  buffer_store_short_d16_hi v128, v74, s[56:59], 0 offen offset:4
  s_cmp_lg_u32 s72, 0
  s_cbranch_scc1 L_done
  s_mov_b64 exec, 1
  buffer_store_dword v15, v74, s[52:55], 0 offen
  s_branch L_done
L_q0:
  s_mov_b32 s73, 1
  s_waitcnt vmcnt(6)
  s_add_u32 s70, s65, 163840
  buffer_load_dwordx4 v[180:183], v5, s[36:39], s70 offen offset:0 nt
  s_add_u32 s70, s65, 196608
  buffer_load_dwordx4 v[184:187], v5, s[36:39], s70 offen offset:0 nt
  v_xor_b32 v52, v228, v92
  v_bitop3_b32 v52, v229, v93, v52 bitop3:0xbe
  v_bitop3_b32 v52, v230, v94, v52 bitop3:0xbe
  v_bitop3_b32 v52, v231, v95, v52 bitop3:0xbe
  v_and_b32 v52, 15, v52
  v_cmp_ne_u32 vcc, 0, v52
  s_cbranch_vccnz L_q1
  ds_write_b128 v54, v[228:231] offset:13888
  s_branch L_qok
L_q1:
  s_mov_b32 s73, 2
  s_waitcnt vmcnt(5)
  s_add_u32 s70, s65, 229376
  buffer_load_dwordx4 v[188:191], v5, s[36:39], s70 offen offset:0 nt
  buffer_load_dwordx4 v[192:195], v6, s[48:51], s66 offen offset:0 nt
  v_xor_b32 v52, v232, v92
  v_bitop3_b32 v52, v233, v93, v52 bitop3:0xbe
  v_bitop3_b32 v52, v234, v94, v52 bitop3:0xbe
  v_bitop3_b32 v52, v235, v95, v52 bitop3:0xbe
  v_and_b32 v52, 15, v52
  v_cmp_ne_u32 vcc, 0, v52
  s_cbranch_vccnz L_q2
  ds_write_b128 v54, v[232:235] offset:13888
  s_branch L_qok
L_q2:
  s_mov_b32 s73, 3
  s_waitcnt vmcnt(5)
  buffer_load_dwordx4 v[196:199], v6, s[48:51], s66 offen offset:1280 nt
  v_xor_b32 v52, v236, v92
  v_bitop3_b32 v52, v237, v93, v52 bitop3:0xbe
  v_bitop3_b32 v52, v238, v94, v52 bitop3:0xbe
  v_bitop3_b32 v52, v239, v95, v52 bitop3:0xbe
  v_and_b32 v52, 15, v52
  v_cmp_ne_u32 vcc, 0, v52
  s_cbranch_vccnz L_q3
  ds_write_b128 v54, v[236:239] offset:13888
  s_branch L_qok
L_q3:
  s_mov_b32 s73, 4
  buffer_load_dwordx4 v[200:203], v6, s[48:51], s66 offen offset:2560 nt
  buffer_load_dwordx4 v[204:207], v6, s[48:51], s66 offen offset:3840 nt
  buffer_load_dwordx4 v[208:211], v6, s[48:51], s71 offen offset:0 nt
  buffer_load_dwordx4 v[212:215], v6, s[48:51], s71 offen offset:1280 nt
  buffer_load_dwordx4 v[216:219], v6, s[48:51], s71 offen offset:2560 nt
  buffer_load_dwordx4 v[220:223], v6, s[48:51], s71 offen offset:3840 nt
  s_mov_b32 s73, 9
  s_mov_b32 s3, 262144
  s_mov_b32 s64, 1048576
L_qs:
  buffer_load_dwordx4 v[224:227], v80, s[52:55], 0 offen offset:0 sc1
  s_waitcnt vmcnt(0)
  v_xor_b32 v52, v224, v92
  v_bitop3_b32 v52, v225, v93, v52 bitop3:0xbe
  v_bitop3_b32 v52, v226, v94, v52 bitop3:0xbe
  v_bitop3_b32 v52, v227, v95, v52 bitop3:0xbe
  v_and_b32 v52, 15, v52
  v_cmp_ne_u32 vcc, 0, v52
  s_cbranch_vccz L_qw
  s_sub_u32 s3, s3, 1
  s_cbranch_scc1 L_qw
  s_cmp_gt_u32 s3, 262112
  s_cbranch_scc1 L_qs
  s_cmp_lt_u32 s3, 262112
  s_cbranch_scc1 L_qs_b
  s_mov_b32 s67, 262144
L_qs_m:
  s_mov_b32 exec_lo, 0xffffffff
  s_mov_b32 exec_hi, 0x0
  buffer_load_dwordx4 v[72:75], v8, s[52:55], s100 offen sc1
  s_sub_u32 s67, s67, 1
  s_cbranch_scc1 L_qs_m_y
  s_waitcnt vmcnt(0)
  v_xor_b32 v52, v72, v92
  v_bitop3_b32 v52, v73, v93, v52 bitop3:0xbe
  v_bitop3_b32 v52, v74, v94, v52 bitop3:0xbe
  v_bitop3_b32 v52, v75, v95, v52 bitop3:0xbe
  v_and_b32 v52, 15, v52
  v_cmp_ne_u32 vcc, 0, v52
  s_cbranch_vccnz L_qs_m
L_qs_m_y:
  s_add_u32 s67, s100, 1048576
  buffer_store_dwordx4 v[72:75], v8, s[52:55], s67 offen sc1
  s_mov_b64 exec, -1
L_qs_b:
  buffer_load_dwordx4 v[224:227], v80, s[52:55], s64 offen offset:0 sc1
  s_waitcnt vmcnt(0)
  v_xor_b32 v52, v224, v92
  v_bitop3_b32 v52, v225, v93, v52 bitop3:0xbe
  v_bitop3_b32 v52, v226, v94, v52 bitop3:0xbe
  v_bitop3_b32 v52, v227, v95, v52 bitop3:0xbe
  v_and_b32 v52, 15, v52
  v_cmp_ne_u32 vcc, 0, v52
  s_cbranch_vccnz L_qs
  s_branch L_qw
L_p1s:
  s_waitcnt vmcnt(0)
  s_mov_b32 s3, 262144
  s_mov_b32 s64, 1048576
L_p1:
  buffer_load_dwordx4 v[56:59], v81, s[52:55], 0 offen offset:768 sc1
  buffer_load_dwordx4 v[48:51], v14, s[52:55], 0 offen offset:0 sc1
  s_waitcnt vmcnt(1)
  v_perm_b32 v52, v57, v56, s10
  v_perm_b32 v53, v59, v58, s10
  v_perm_b32 v52, v53, v52, s11
  v_cmp_ne_u32 s[4:5], v52, v15
  s_waitcnt vmcnt(0)
  v_perm_b32 v52, v49, v48, s10
  v_perm_b32 v53, v51, v50, s10
  v_perm_b32 v52, v53, v52, s11
  v_cmp_ne_u32 vcc, v52, v15
  s_nop 0
  s_or_b64 vcc, vcc, s[4:5]
  s_cbranch_vccz L_p1y
  s_sub_u32 s3, s3, 1
  s_cbranch_scc1 L_p1y
  s_cmp_gt_u32 s3, 262143
  s_cbranch_scc1 L_p1
  s_cmp_lt_u32 s3, 262143
  s_cbranch_scc1 L_p1_b
  s_mov_b32 s67, 262144
L_p1_m:
  s_mov_b32 exec_lo, 0xffffffff
  s_mov_b32 exec_hi, 0x0
  buffer_load_dwordx4 v[72:75], v8, s[52:55], s100 offen sc1
  s_mov_b32 exec_hi, 0x00ffffff
  buffer_load_dwordx4 v[64:67], v8, s[52:55], s101 offen sc1
  s_sub_u32 s67, s67, 1
  s_cbranch_scc1 L_p1_m_y
  s_waitcnt vmcnt(0)
  v_perm_b32 v52, v65, v64, s10
  v_perm_b32 v53, v67, v66, s10
  v_perm_b32 v52, v53, v52, s11
  v_cmp_ne_u32 vcc, v52, v15
  s_cbranch_vccnz L_p1_m
  s_mov_b32 exec_hi, 0
  v_xor_b32 v52, v72, v92
  v_bitop3_b32 v52, v73, v93, v52 bitop3:0xbe
  v_bitop3_b32 v52, v74, v94, v52 bitop3:0xbe
  v_bitop3_b32 v52, v75, v95, v52 bitop3:0xbe
  v_and_b32 v52, 15, v52
  v_cmp_ne_u32 vcc, 0, v52
  s_cbranch_vccnz L_p1_m
L_p1_m_y:
  s_add_u32 s67, s100, 1048576
  buffer_store_dwordx4 v[72:75], v8, s[52:55], s67 offen sc1
  s_mov_b32 exec_hi, 0x00ffffff
  s_add_u32 s70, s101, 1048576
  buffer_store_dwordx4 v[64:67], v8, s[52:55], s70 offen sc1
  s_mov_b64 exec, -1
L_p1_b:
  buffer_load_dwordx4 v[56:59], v81, s[52:55], s64 offen offset:768 sc1
  buffer_load_dwordx4 v[48:51], v14, s[52:55], s64 offen offset:0 sc1
  s_waitcnt vmcnt(1)
  v_perm_b32 v52, v57, v56, s10
  v_perm_b32 v53, v59, v58, s10
  v_perm_b32 v52, v53, v52, s11
  v_cmp_ne_u32 s[4:5], v52, v15
  s_waitcnt vmcnt(0)
  v_perm_b32 v52, v49, v48, s10
  v_perm_b32 v53, v51, v50, s10
  v_perm_b32 v52, v53, v52, s11
  v_cmp_ne_u32 vcc, v52, v15
  s_nop 0
  s_or_b64 vcc, vcc, s[4:5]
  s_cbranch_vccnz L_p1
  s_branch L_p1y
L_p1y:
  v_and_b32 v55, 0xffff0000, v56
  s_nop 0
  s_branch L_p1x
L_em:
  s_mov_b32 s67, 262144
L_emm:
  s_mov_b32 exec_lo, 0xffffffff
  s_mov_b32 exec_hi, 0x0
  buffer_load_dwordx4 v[72:75], v8, s[52:55], s100 offen sc1
  s_mov_b32 exec_hi, 0x00ffffff
  buffer_load_dwordx4 v[64:67], v8, s[52:55], s101 offen sc1
  s_sub_u32 s67, s67, 1
  s_cbranch_scc1 L_emm_y
  s_waitcnt vmcnt(0)
  v_perm_b32 v52, v65, v64, s10
  v_perm_b32 v53, v67, v66, s10
  v_perm_b32 v52, v53, v52, s11
  v_cmp_ne_u32 vcc, v52, v15
  s_cbranch_vccnz L_emm
  s_mov_b32 exec_hi, 0
  v_xor_b32 v52, v72, v92
  v_bitop3_b32 v52, v73, v93, v52 bitop3:0xbe
  v_bitop3_b32 v52, v74, v94, v52 bitop3:0xbe
  v_bitop3_b32 v52, v75, v95, v52 bitop3:0xbe
  v_and_b32 v52, 15, v52
  v_cmp_ne_u32 vcc, 0, v52
  s_cbranch_vccnz L_emm
L_emm_y:
  s_add_u32 s67, s100, 1048576
  buffer_store_dwordx4 v[72:75], v8, s[52:55], s67 offen sc1
  s_mov_b32 exec_hi, 0x00ffffff
  s_add_u32 s70, s101, 1048576
  buffer_store_dwordx4 v[64:67], v8, s[52:55], s70 offen sc1
  s_mov_b64 exec, -1
L_done:
L_end:
  s_endpgm
.section .rodata,"a"
.p2align 6
.amdhsa_kernel parallel_sum__sliding_block_cached__dense_activation_silu__decode_kernel
  .amdhsa_next_free_vgpr 240
  .amdhsa_next_free_sgpr 102
  .amdhsa_accum_offset 240
  .amdhsa_group_segment_fixed_size 0
  .amdhsa_kernarg_size 88
  .amdhsa_user_sgpr_count 2
  .amdhsa_user_sgpr_kernarg_segment_ptr 1
  .amdhsa_system_sgpr_workgroup_id_x 1
.end_amdhsa_kernel
```
